```python
import torch

def _softmax(x, axis=-1):
    return torch.softmax(x, dim=axis)
def _gelu(x):
    return torch.nn.functional.gelu(x, approximate="tanh")
def _silu(x):
    return torch.nn.functional.silu(x)
def _sigmoid(x):
    return torch.sigmoid(x)
def _layernorm(x, axis=-1, eps=1e-5):
    m = x.mean(dim=axis, keepdim=True)
    v = x.var(dim=axis, keepdim=True, unbiased=False)
    return (x - m) / torch.sqrt(v + eps)
def _scatter_add(tgt, idx, src, axis=0):
    return tgt.clone().index_add_(axis, idx, src)
def _segment_sum(src, seg, n):
    out = torch.zeros((n,) + src.shape[1:], dtype=src.dtype)
    return out.index_add_(0, seg, src)
def _pad(x, pw):
    flat = tuple(v for pair in reversed(pw) for v in pair)
    return torch.nn.functional.pad(x, flat)

kernel_name = 'standalone__channel_attn_eca__vision'

def setup_inputs():

    _w = (lambda a: (lambda t: t.to(torch.bfloat16) if t.is_floating_point() else t)(torch.as_tensor(a)))
    H = W = 384
    C = 96
    k = 3
    return {
        "x": _w((lambda *s: torch.randn(*s, dtype=torch.bfloat16) * 0.2)(1, H, W, C) + (lambda *s: torch.randn(*s, dtype=torch.bfloat16) * 0.2)(1, 1, 1, C) * 2.0),
        "w1d": _w((lambda *s: torch.randn(*s, dtype=torch.bfloat16) * 0.4)(k)),
    }

def reference(x, w1d):
    B, H, W, C = x.shape
    k = 3
    pad = k // 2
    g = torch.einsum("bhwc->bc", x) / (H * W)
    gp = _pad(g, ((0, 0), (pad, pad)))
    s = torch.zeros_like(g)
    for i in range(k):
        s = s + gp[:, i:i + C] * w1d[i]
    s = _sigmoid(s)
    return x * s[:, None, None, :]
```

```asm
; @launch grid=(256,1,1) block=(832,1,1) lds=26128
.amdgcn_target "amdgcn-amd-amdhsa--gfx950"
.text
.p2align 12
.fill 832, 4, 0xbf810000
.globl standalone__channel_attn_eca__vision_kernel
.p2align 8
.type standalone__channel_attn_eca__vision_kernel,@function
standalone__channel_attn_eca__vision_kernel:
    s_load_dwordx8 s[4:11], s[0:1], 0
    s_load_dwordx2 s[12:13], s[0:1], 32
    v_lshrrev_b32 v2, 6, v0
    v_and_b32 v4, 63, v0
    s_cmp_ge_u32 s2, 256
    s_cbranch_scc1 L_exit
    v_readfirstlane_b32 s3, v2
    v_lshlrev_b32 v1, 4, v4
    s_lshr_b32 s37, s2, 3
    s_lshl_b32 s56, s37, 2
    s_and_b32 s57, s2, 3
    s_add_u32 s56, s56, s57
    s_bfe_u32 s57, s2, 0x10002
    s_mul_i32 s58, s56, 221184
    s_cmp_eq_u32 s3, 0
    s_cbranch_scc0 L_data
    s_lshl_b32 s42, s57, 7
    s_add_u32 s42, s42, s58
    v_add_u32 v2, s42, v1
    v_add_u32 v3, 0x2000, v2
    s_mov_b64 exec, 0xff
    s_waitcnt lgkmcnt(0)
    global_store_dwordx4 v2, v[0:3], s[8:9] sc1
    global_store_dwordx4 v3, v[0:3], s[8:9] sc1
    s_load_dword s41, s[12:13], 0
    s_lshl_b32 s42, s56, 7
    s_add_u32 s42, s42, 0x8000
    v_mov_b32 v5, 26112
    s_waitcnt vmcnt(1)
    s_add_u32 s46, s12, s42
    s_addc_u32 s47, s13, 0
    s_getreg_b32 s48, hwreg(HW_REG_IB_STS, 0, 1)
    s_waitcnt lgkmcnt(0)
    s_mul_i32 s41, s41, 0x9e3779b1
    s_add_u32 s41, s41, 0x7f4a7c15
    s_xor_b32 s48, s48, s57
    s_lshl_b32 s49, s41, 1
    s_or_b32 s50, s49, s48
    s_atomic_swap s50, s[46:47], 0 glc
    v_mov_b32 v16, s41
    s_waitcnt lgkmcnt(0)
    s_xor_b32 s51, s50, s49
    s_cmp_lt_u32 s51, 2
    s_cselect_b32 s48, s51, s48
    s_xor_b32 s48, s48, s57
    v_mov_b32 v17, s48
    ds_write_b64 v5, v[16:17]
    s_waitcnt vmcnt(0) lgkmcnt(0)
    s_barrier
    s_branch L_control
L_data:
    s_sub_u32 s3, s3, 1
    s_lshr_b32 s42, s3, 2
    s_lshl_b32 s43, s57, 1
    s_add_u32 s43, s43, s42
    s_add_u32 s44, s43, 3
    s_and_b32 s44, s44, 3
    s_lshl_b32 s45, s3, 10
    s_add_u32 s58, s58, s45
    s_mul_i32 s20, s44, 12288
    s_add_u32 s20, s20, s58
    s_mov_b32 s18, 28311552
    s_mov_b32 s19, 0x20000
    s_waitcnt lgkmcnt(0)
    s_mov_b32 s16, s4
    s_and_b32 s17, s5, 0xffff
    buffer_load_dwordx4 v[12:15], v1, s[16:19], s20 offen nt
    s_xor_b32 s44, s44, 2
    s_mul_i32 s21, s44, 12288
    s_add_u32 s21, s21, s58
    s_add_u32 s21, s21, 49152
    buffer_load_dwordx4 v[20:23], v1, s[16:19], s21 offen nt
    s_add_u32 s22, s20, 98304
    buffer_load_dwordx4 v[28:31], v1, s[16:19], s22 offen nt
    s_add_u32 s23, s21, 98304
    buffer_load_dwordx4 v[36:39], v1, s[16:19], s23 offen nt
    s_mul_i32 s24, s57, 12288
    s_add_u32 s24, s24, s58
    s_add_u32 s24, s24, 196608
    buffer_load_dwordx4 v[44:47], v1, s[16:19], s24 offen nt
    s_and_b32 s43, s43, 3
    s_mul_i32 s43, s43, 12288
    s_add_u32 s25, s43, s58
    buffer_load_dwordx4 v[52:55], v1, s[16:19], s25 offen nt
L_issued:
    s_and_b32 s36, s2, 7
    s_lshl_b32 s38, s36, 14
    s_add_u32 s38, s38, 0x10000
    s_lshl_b32 s39, s37, 9
    s_add_u32 s39, s39, s38
    s_mov_b32 s31, 0xffff0000
    s_mul_i32 s48, s42, 12288
    s_add_u32 s42, s42, 2
    s_and_b32 s42, s42, 3
    s_mul_i32 s49, s42, 12288
    s_add_u32 s58, s58, 49152
    s_add_u32 s48, s48, s58
    s_add_u32 s49, s49, s58
    s_mov_b32 s32, s8
    s_and_b32 s33, s9, 0xffff
    s_mov_b32 s34, 28311552
    s_mov_b32 s35, 0x20000
    v_mov_b32 v5, 26112
    v_subrev_u32 v0, 64, v0
    s_barrier
    ds_read_b64 v[6:7], v5
    s_waitcnt lgkmcnt(0)
    v_readfirstlane_b32 s42, v7
    v_readfirstlane_b32 s41, v6
    s_cmp_eq_u32 s42, 0
    s_cselect_b32 s26, s49, s48
    buffer_load_dwordx4 v[60:63], v1, s[16:19], s26 offen nt
    s_add_u32 s27, s26, 49152
    buffer_load_dwordx4 v[68:71], v1, s[16:19], s27 offen nt
    s_add_u32 s28, s26, 98304
    buffer_load_dwordx4 v[76:79], v1, s[16:19], s28 offen nt
    v_mul_u32_u24 v2, 0x5556, v0
    v_lshrrev_b32 v2, 18, v2
    v_mul_u32_u24 v3, 12, v2
    v_sub_u32 v3, v0, v3
    v_mul_u32_u24 v2, 400, v2
    v_lshlrev_b32 v3, 4, v3
    v_add_u32 v2, v2, v3
    v_mul_u32_u24 v5, 400, v4
    s_mul_i32 s30, s3, 3
    s_add_u32 s42, s30, 0
    s_and_b32 s43, s42, 1
    s_mul_i32 s43, s43, 192
    s_lshr_b32 s42, s42, 1
    s_lshl_b32 s42, s42, 4
    s_add_u32 s42, s42, s43
    v_add_u32 v90, s42, v5
    s_add_u32 s42, s30, 1
    s_and_b32 s43, s42, 1
    s_mul_i32 s43, s43, 192
    s_lshr_b32 s42, s42, 1
    s_lshl_b32 s42, s42, 4
    s_add_u32 s42, s42, s43
    v_add_u32 v91, s42, v5
    s_add_u32 s42, s30, 2
    s_and_b32 s43, s42, 1
    s_mul_i32 s43, s43, 192
    s_lshr_b32 s42, s42, 1
    s_lshl_b32 s42, s42, 4
    s_add_u32 s42, s42, s43
    v_add_u32 v5, s42, v5
    s_lshl_b32 s43, s3, 6
    s_add_u32 s42, s43, s39
    v_lshrrev_b32 v7, 4, v4
    v_lshl_add_u32 v7, v7, 4, s42
    s_mov_b32 s44, 0x00010001
    s_mov_b32 s45, 0x00010001
    s_waitcnt vmcnt(8)
    v_lshlrev_b32 v8, 16, v12
    v_and_b32 v9, s31, v12
    v_lshlrev_b32 v10, 16, v13
    v_and_b32 v11, s31, v13
    v_lshlrev_b32 v12, 16, v14
    v_and_b32 v13, s31, v14
    v_lshlrev_b32 v14, 16, v15
    v_and_b32 v15, s31, v15
    s_waitcnt vmcnt(7)
    v_lshlrev_b32 v16, 16, v20
    v_and_b32 v17, s31, v20
    v_lshlrev_b32 v18, 16, v21
    v_and_b32 v19, s31, v21
    v_lshlrev_b32 v20, 16, v22
    v_and_b32 v21, s31, v22
    v_lshlrev_b32 v22, 16, v23
    v_and_b32 v23, s31, v23
    v_pk_add_f32 v[80:81], v[8:9], v[16:17]
    v_pk_add_f32 v[82:83], v[10:11], v[18:19]
    v_pk_add_f32 v[84:85], v[12:13], v[20:21]
    v_pk_add_f32 v[86:87], v[14:15], v[22:23]
    s_waitcnt vmcnt(6)
    v_lshlrev_b32 v24, 16, v28
    v_and_b32 v25, s31, v28
    v_lshlrev_b32 v26, 16, v29
    v_and_b32 v27, s31, v29
    v_lshlrev_b32 v28, 16, v30
    v_and_b32 v29, s31, v30
    v_lshlrev_b32 v30, 16, v31
    v_and_b32 v31, s31, v31
    v_pk_add_f32 v[80:81], v[80:81], v[24:25]
    v_pk_add_f32 v[82:83], v[82:83], v[26:27]
    v_pk_add_f32 v[84:85], v[84:85], v[28:29]
    v_pk_add_f32 v[86:87], v[86:87], v[30:31]
    s_waitcnt vmcnt(5)
    v_lshlrev_b32 v32, 16, v36
    v_and_b32 v33, s31, v36
    v_lshlrev_b32 v34, 16, v37
    v_and_b32 v35, s31, v37
    v_lshlrev_b32 v36, 16, v38
    v_and_b32 v37, s31, v38
    v_lshlrev_b32 v38, 16, v39
    v_and_b32 v39, s31, v39
    v_pk_add_f32 v[80:81], v[80:81], v[32:33]
    v_pk_add_f32 v[82:83], v[82:83], v[34:35]
    v_pk_add_f32 v[84:85], v[84:85], v[36:37]
    v_pk_add_f32 v[86:87], v[86:87], v[38:39]
    s_waitcnt vmcnt(4)
    v_lshlrev_b32 v40, 16, v44
    v_and_b32 v41, s31, v44
    v_lshlrev_b32 v42, 16, v45
    v_and_b32 v43, s31, v45
    v_lshlrev_b32 v44, 16, v46
    v_and_b32 v45, s31, v46
    v_lshlrev_b32 v46, 16, v47
    v_and_b32 v47, s31, v47
    v_pk_add_f32 v[80:81], v[80:81], v[40:41]
    v_pk_add_f32 v[82:83], v[82:83], v[42:43]
    v_pk_add_f32 v[84:85], v[84:85], v[44:45]
    v_pk_add_f32 v[86:87], v[86:87], v[46:47]
    s_waitcnt vmcnt(3)
    v_lshlrev_b32 v48, 16, v52
    v_and_b32 v49, s31, v52
    v_lshlrev_b32 v50, 16, v53
    v_and_b32 v51, s31, v53
    v_lshlrev_b32 v52, 16, v54
    v_and_b32 v53, s31, v54
    v_lshlrev_b32 v54, 16, v55
    v_and_b32 v55, s31, v55
    v_pk_add_f32 v[80:81], v[80:81], v[48:49]
    v_pk_add_f32 v[82:83], v[82:83], v[50:51]
    v_pk_add_f32 v[84:85], v[84:85], v[52:53]
    v_pk_add_f32 v[86:87], v[86:87], v[54:55]
    s_waitcnt vmcnt(2)
    v_lshlrev_b32 v56, 16, v60
    v_and_b32 v57, s31, v60
    v_lshlrev_b32 v58, 16, v61
    v_and_b32 v59, s31, v61
    v_lshlrev_b32 v60, 16, v62
    v_and_b32 v61, s31, v62
    v_lshlrev_b32 v62, 16, v63
    v_and_b32 v63, s31, v63
    v_pk_add_f32 v[80:81], v[80:81], v[56:57]
    v_pk_add_f32 v[82:83], v[82:83], v[58:59]
    v_pk_add_f32 v[84:85], v[84:85], v[60:61]
    v_pk_add_f32 v[86:87], v[86:87], v[62:63]
    s_waitcnt vmcnt(1)
    v_lshlrev_b32 v64, 16, v68
    v_and_b32 v65, s31, v68
    v_lshlrev_b32 v66, 16, v69
    v_and_b32 v67, s31, v69
    v_lshlrev_b32 v68, 16, v70
    v_and_b32 v69, s31, v70
    v_lshlrev_b32 v70, 16, v71
    v_and_b32 v71, s31, v71
    v_pk_add_f32 v[80:81], v[80:81], v[64:65]
    v_pk_add_f32 v[82:83], v[82:83], v[66:67]
    v_pk_add_f32 v[84:85], v[84:85], v[68:69]
    v_pk_add_f32 v[86:87], v[86:87], v[70:71]
    s_waitcnt vmcnt(0)
    v_lshlrev_b32 v72, 16, v76
    v_and_b32 v73, s31, v76
    v_lshlrev_b32 v74, 16, v77
    v_and_b32 v75, s31, v77
    v_lshlrev_b32 v76, 16, v78
    v_and_b32 v77, s31, v78
    v_lshlrev_b32 v78, 16, v79
    v_and_b32 v79, s31, v79
    v_pk_add_f32 v[80:81], v[80:81], v[72:73]
    v_pk_add_f32 v[82:83], v[82:83], v[74:75]
    ds_write_b128 v2, v[80:83]
    v_pk_add_f32 v[84:85], v[84:85], v[76:77]
    v_pk_add_f32 v[86:87], v[86:87], v[78:79]
    ds_write_b128 v2, v[84:87] offset:192
    s_cmp_ge_u32 s3, 8
    s_waitcnt lgkmcnt(0)
    s_barrier
    s_cbranch_scc1 L_final
    ds_read_b128 v[92:95], v90
    ds_read_b128 v[96:99], v91
    ds_read_b128 v[100:103], v5
    s_waitcnt lgkmcnt(1)
    v_permlane32_swap_b32 v92, v98
    v_permlane32_swap_b32 v93, v99
    v_pk_add_f32 v[92:93], v[92:93], v[98:99]
    s_waitcnt lgkmcnt(0)
    v_permlane32_swap_b32 v94, v100
    v_permlane32_swap_b32 v95, v101
    v_permlane32_swap_b32 v96, v102
    v_permlane32_swap_b32 v97, v103
    v_pk_add_f32 v[94:95], v[94:95], v[100:101]
    v_pk_add_f32 v[96:97], v[96:97], v[102:103]
    v_mov_b32 v99, s41
    v_permlane16_swap_b32 v92, v95
    v_permlane16_swap_b32 v93, v96
    v_permlane16_swap_b32 v94, v97
    v_add_f32 v98, v94, v97
    v_add_f32 v97, v93, v96
    v_add_f32 v96, v92, v95
    v_add_f32_dpp v98, v98, v98 row_ror:8 row_mask:0xf bank_mask:0xf
    v_add_f32_dpp v97, v97, v97 row_ror:8 row_mask:0xf bank_mask:0xf
    v_add_f32_dpp v96, v96, v96 row_ror:8 row_mask:0xf bank_mask:0xf
    v_add_f32_dpp v98, v98, v98 row_half_mirror row_mask:0xf bank_mask:0xf
    v_add_f32_dpp v97, v97, v97 row_half_mirror row_mask:0xf bank_mask:0xf
    v_add_f32_dpp v96, v96, v96 row_half_mirror row_mask:0xf bank_mask:0xf
    v_add_f32_dpp v98, v98, v98 quad_perm:[1,0,3,2] row_mask:0xf bank_mask:0xf
    v_add_f32_dpp v97, v97, v97 quad_perm:[1,0,3,2] row_mask:0xf bank_mask:0xf
    v_add_f32_dpp v96, v96, v96 quad_perm:[1,0,3,2] row_mask:0xf bank_mask:0xf
    v_add_f32_dpp v98, v98, v98 quad_perm:[2,3,0,1] row_mask:0xf bank_mask:0xf
    v_add_f32_dpp v97, v97, v97 quad_perm:[2,3,0,1] row_mask:0xf bank_mask:0xf
    v_add_f32_dpp v96, v96, v96 quad_perm:[2,3,0,1] row_mask:0xf bank_mask:0xf
    s_mov_b64 exec, s[44:45]
    global_store_dwordx4 v7, v[96:99], s[12:13]
    s_mov_b64 exec, -1
L_final:
    s_barrier
    ds_read_b128 v[80:83], v3 offset:25600
    ds_read_b128 v[84:87], v3 offset:25792
    s_waitcnt lgkmcnt(0)
    v_pk_mul_f32 v[8:9], v[8:9], v[80:81]
    v_pk_mul_f32 v[10:11], v[10:11], v[82:83]
    v_pk_mul_f32 v[12:13], v[12:13], v[84:85]
    v_pk_mul_f32 v[14:15], v[14:15], v[86:87]
    v_cvt_pk_bf16_f32 v8, v8, v9
    v_cvt_pk_bf16_f32 v9, v10, v11
    v_cvt_pk_bf16_f32 v10, v12, v13
    v_cvt_pk_bf16_f32 v11, v14, v15
    buffer_store_dwordx4 v[8:11], v1, s[32:35], s20 offen sc1
    v_pk_mul_f32 v[16:17], v[16:17], v[80:81]
    v_pk_mul_f32 v[18:19], v[18:19], v[82:83]
    v_pk_mul_f32 v[20:21], v[20:21], v[84:85]
    v_pk_mul_f32 v[22:23], v[22:23], v[86:87]
    v_cvt_pk_bf16_f32 v16, v16, v17
    v_cvt_pk_bf16_f32 v17, v18, v19
    v_cvt_pk_bf16_f32 v18, v20, v21
    v_cvt_pk_bf16_f32 v19, v22, v23
    buffer_store_dwordx4 v[16:19], v1, s[32:35], s21 offen sc1
    v_pk_mul_f32 v[24:25], v[24:25], v[80:81]
    v_pk_mul_f32 v[26:27], v[26:27], v[82:83]
    v_pk_mul_f32 v[28:29], v[28:29], v[84:85]
    v_pk_mul_f32 v[30:31], v[30:31], v[86:87]
    v_cvt_pk_bf16_f32 v24, v24, v25
    v_cvt_pk_bf16_f32 v25, v26, v27
    v_cvt_pk_bf16_f32 v26, v28, v29
    v_cvt_pk_bf16_f32 v27, v30, v31
    buffer_store_dwordx4 v[24:27], v1, s[32:35], s22 offen sc1
    v_pk_mul_f32 v[32:33], v[32:33], v[80:81]
    v_pk_mul_f32 v[34:35], v[34:35], v[82:83]
    v_pk_mul_f32 v[36:37], v[36:37], v[84:85]
    v_pk_mul_f32 v[38:39], v[38:39], v[86:87]
    v_cvt_pk_bf16_f32 v32, v32, v33
    v_cvt_pk_bf16_f32 v33, v34, v35
    v_cvt_pk_bf16_f32 v34, v36, v37
    v_cvt_pk_bf16_f32 v35, v38, v39
    buffer_store_dwordx4 v[32:35], v1, s[32:35], s23 offen sc1
    v_pk_mul_f32 v[40:41], v[40:41], v[80:81]
    v_pk_mul_f32 v[42:43], v[42:43], v[82:83]
    v_pk_mul_f32 v[44:45], v[44:45], v[84:85]
    v_pk_mul_f32 v[46:47], v[46:47], v[86:87]
    v_cvt_pk_bf16_f32 v40, v40, v41
    v_cvt_pk_bf16_f32 v41, v42, v43
    v_cvt_pk_bf16_f32 v42, v44, v45
    v_cvt_pk_bf16_f32 v43, v46, v47
    buffer_store_dwordx4 v[40:43], v1, s[32:35], s24 offen sc1
    v_pk_mul_f32 v[48:49], v[48:49], v[80:81]
    v_pk_mul_f32 v[50:51], v[50:51], v[82:83]
    v_pk_mul_f32 v[52:53], v[52:53], v[84:85]
    v_pk_mul_f32 v[54:55], v[54:55], v[86:87]
    v_cvt_pk_bf16_f32 v48, v48, v49
    v_cvt_pk_bf16_f32 v49, v50, v51
    v_cvt_pk_bf16_f32 v50, v52, v53
    v_cvt_pk_bf16_f32 v51, v54, v55
    buffer_store_dwordx4 v[48:51], v1, s[32:35], s25 offen sc1
    v_pk_mul_f32 v[56:57], v[56:57], v[80:81]
    v_pk_mul_f32 v[58:59], v[58:59], v[82:83]
    v_pk_mul_f32 v[60:61], v[60:61], v[84:85]
    v_pk_mul_f32 v[62:63], v[62:63], v[86:87]
    v_cvt_pk_bf16_f32 v56, v56, v57
    v_cvt_pk_bf16_f32 v57, v58, v59
    v_cvt_pk_bf16_f32 v58, v60, v61
    v_cvt_pk_bf16_f32 v59, v62, v63
    buffer_store_dwordx4 v[56:59], v1, s[32:35], s26 offen sc1
    v_pk_mul_f32 v[64:65], v[64:65], v[80:81]
    v_pk_mul_f32 v[66:67], v[66:67], v[82:83]
    v_pk_mul_f32 v[68:69], v[68:69], v[84:85]
    v_pk_mul_f32 v[70:71], v[70:71], v[86:87]
    v_cvt_pk_bf16_f32 v64, v64, v65
    v_cvt_pk_bf16_f32 v65, v66, v67
    v_cvt_pk_bf16_f32 v66, v68, v69
    v_cvt_pk_bf16_f32 v67, v70, v71
    buffer_store_dwordx4 v[64:67], v1, s[32:35], s27 offen sc1
    v_pk_mul_f32 v[72:73], v[72:73], v[80:81]
    v_pk_mul_f32 v[74:75], v[74:75], v[82:83]
    v_pk_mul_f32 v[76:77], v[76:77], v[84:85]
    v_pk_mul_f32 v[78:79], v[78:79], v[86:87]
    v_cvt_pk_bf16_f32 v72, v72, v73
    v_cvt_pk_bf16_f32 v73, v74, v75
    v_cvt_pk_bf16_f32 v74, v76, v77
    v_cvt_pk_bf16_f32 v75, v78, v79
    buffer_store_dwordx4 v[72:75], v1, s[32:35], s28 offen sc1
L_exit:
    s_endpgm
L_control:
    s_mov_b64 exec, -1
    s_and_b32 s36, s2, 7
    s_lshl_b32 s38, s36, 14
    s_add_u32 s38, s38, 0x10000
    s_lshl_b32 s39, s37, 9
    s_add_u32 s39, s39, s38
    s_mov_b32 s31, 0xffff0000
    v_mov_b32 v6, 0
    s_and_b32 s59, s37, 1
    s_lshl_b32 s59, s59, 13
    s_add_u32 s59, s59, 0x80000
    s_bfe_u32 s43, s37, 0x30001
    s_lshl_b32 s43, s43, 9
    s_add_u32 s44, s43, s59
    s_sub_u32 s44, s44, 512
    v_mov_b32 v12, s39
    v_mov_b32 v13, s44
    v_cmp_gt_u32 vcc, 32, v4
    s_add_u32 s43, s43, 0x84000
    v_add_u32 v14, s43, v1
    v_cndmask_b32 v12, v13, v12, vcc
    v_add_u32 v12, v12, v1
    global_load_dwordx4 v[92:95], v12, s[12:13] sc1
    s_mov_b32 exec_hi, 0
    global_load_dwordx4 v[96:99], v14, s[12:13] sc1
    s_mov_b32 exec_hi, -1
    global_load_ushort v89, v6, s[6:7] offset:4
    s_load_dword s14, s[6:7], 0
    s_lshl_b32 s43, s37, 7
    s_add_u32 s42, s43, s38
    s_add_u32 s42, s42, 4096
    v_lshrrev_b32 v20, 3, v4
    v_lshlrev_b32 v20, 9, v20
    v_and_b32 v5, 7, v4
    v_lshl_add_u32 v20, v5, 4, v20
    v_add_u32 v20, s42, v20
    v_add_u32 v21, 8192, v20
    s_lshl_b32 s42, s36, 9
    s_add_u32 s42, s42, s43
    s_add_u32 s42, s42, 0x80000
    v_lshl_add_u32 v22, v4, 4, s42
    v_add_u32 v23, 0x2000, v22
    v_add_u32 v24, 0x4000, v22
    v_add_u32 v7, s59, v1
    v_lshrrev_b32 v5, 5, v4
    s_sub_u32 s42, 0x84000, s59
    v_mov_b32 v25, s42
    v_add_u32 v26, 0, v5
    v_cmp_eq_u32 vcc, s36, v26
    v_add_u32 v28, 0, v7
    v_add_u32 v27, v28, v25
    v_cndmask_b32 v28, v28, v27, vcc
    v_add_u32 v26, 2, v5
    v_cmp_eq_u32 vcc, s36, v26
    v_add_u32 v29, 1024, v7
    v_add_u32 v27, v29, v25
    v_cndmask_b32 v29, v29, v27, vcc
    v_add_u32 v26, 4, v5
    v_cmp_eq_u32 vcc, s36, v26
    v_add_u32 v30, 2048, v7
    v_add_u32 v27, v30, v25
    v_cndmask_b32 v30, v30, v27, vcc
    v_add_u32 v26, 6, v5
    v_cmp_eq_u32 vcc, s36, v26
    v_add_u32 v31, 3072, v7
    v_add_u32 v27, v31, v25
    v_cndmask_b32 v31, v31, v27, vcc
    v_mul_u32_u24 v5, 3, v4
    v_add_u32 v26, 0, v5
    v_bfe_u32 v27, v26, 2, 1
    v_mul_u32_u24 v27, 192, v27
    v_lshrrev_b32 v25, 3, v26
    v_lshl_add_u32 v27, v25, 4, v27
    v_and_b32 v26, 3, v26
    v_lshl_add_u32 v27, v26, 2, v27
    v_add_u32 v32, 25600, v27
    v_add_u32 v26, 1, v5
    v_bfe_u32 v27, v26, 2, 1
    v_mul_u32_u24 v27, 192, v27
    v_lshrrev_b32 v25, 3, v26
    v_lshl_add_u32 v27, v25, 4, v27
    v_and_b32 v26, 3, v26
    v_lshl_add_u32 v27, v26, 2, v27
    v_add_u32 v33, 25600, v27
    v_add_u32 v26, 2, v5
    v_bfe_u32 v27, v26, 2, 1
    v_mul_u32_u24 v27, 192, v27
    v_lshrrev_b32 v25, 3, v26
    v_lshl_add_u32 v27, v25, 4, v27
    v_and_b32 v26, 3, v26
    v_lshl_add_u32 v27, v26, 2, v27
    v_add_u32 v34, 25600, v27
    s_lshl_b32 s42, s36, 9
    s_add_u32 s42, s42, 0x8400c
    v_mov_b32 v35, s42
    s_mov_b32 s90, 0x36e38e39
    s_mov_b32 s91, 0x36e38e39
    s_mov_b32 s92, 0xbfb8aa3b
    s_mov_b32 s93, 0xbfb8aa3b
    s_waitcnt lgkmcnt(0)
    s_lshl_b32 s52, s14, 16
    s_and_b32 s53, s14, s31
    s_mov_b32 s40, 40
    s_cmp_ge_u32 s37, 4
    s_barrier
    s_cbranch_scc1 L_consumer
L_fastloop:
    global_load_dwordx4 v[92:95], v20, s[12:13] offset:-4096 sc1
    global_load_dwordx4 v[96:99], v20, s[12:13] sc1
    global_load_dwordx4 v[100:103], v21, s[12:13] offset:-4096 sc1
    global_load_dwordx4 v[104:107], v21, s[12:13] sc1
    s_sub_u32 s40, s40, 1
    s_cbranch_scc1 L_toslow
    s_waitcnt vmcnt(2)
    v_cmp_ne_u32 s[46:47], s41, v95
    v_cmp_ne_u32 s[48:49], s41, v99
    s_waitcnt vmcnt(0)
    v_cmp_ne_u32 s[50:51], s41, v103
    v_cmp_ne_u32 vcc, s41, v107
    s_or_b64 s[46:47], s[46:47], s[48:49]
    s_or_b64 vcc, vcc, s[50:51]
    s_or_b64 vcc, vcc, s[46:47]
    s_cbranch_vccnz L_fastloop
L_reddone:
    v_pk_add_f32 v[92:93], v[92:93], v[96:97]
    v_pk_add_f32 v[100:101], v[100:101], v[104:105]
    v_add_f32 v94, v94, v98
    v_add_f32 v102, v102, v106
    v_pk_add_f32 v[92:93], v[92:93], v[100:101]
    v_add_f32 v94, v94, v102
    s_nop 0
    v_add_f32_dpp v92, v92, v92 row_ror:8 row_mask:0xf bank_mask:0xf
    v_add_f32_dpp v93, v93, v93 row_ror:8 row_mask:0xf bank_mask:0xf
    v_add_f32_dpp v94, v94, v94 row_ror:8 row_mask:0xf bank_mask:0xf
    s_mov_b32 s40, 40
    v_permlane16_swap_b32 v92, v96
    v_permlane16_swap_b32 v93, v97
    v_permlane16_swap_b32 v94, v98
    v_pk_add_f32 v[92:93], v[92:93], v[96:97]
    v_add_f32 v94, v94, v98
    s_nop 0
    v_permlane32_swap_b32 v92, v96
    v_permlane32_swap_b32 v93, v97
    v_permlane32_swap_b32 v94, v98
    v_pk_add_f32 v[92:93], v[92:93], v[96:97]
    v_add_f32 v94, v94, v98
    s_mov_b64 exec, 0xff
    global_store_dwordx4 v22, v[92:95], s[12:13] sc1
    global_store_dwordx4 v23, v[92:95], s[12:13] sc1
    global_store_dwordx4 v24, v[92:95], s[12:13]
    s_mov_b64 exec, -1
    s_branch L_conloop
L_consumer:
    s_mov_b32 s40, 56
    s_mov_b64 exec, 1
L_preloop:
    global_load_dword v92, v35, s[12:13] sc1
    s_sub_u32 s40, s40, 1
    s_cbranch_scc1 L_preout
    s_waitcnt vmcnt(0)
    v_cmp_ne_u32 vcc, s41, v92
    s_cbranch_vccnz L_preloop
    s_mov_b64 exec, -1
    s_mov_b32 s40, 40
L_conloop:
    global_load_dwordx4 v[92:95], v28, s[12:13] sc1
    global_load_dwordx4 v[96:99], v29, s[12:13] sc1
    global_load_dwordx4 v[100:103], v30, s[12:13] sc1
    global_load_dwordx4 v[104:107], v31, s[12:13] sc1
    s_sub_u32 s40, s40, 1
    s_cbranch_scc1 L_preout
    s_waitcnt vmcnt(2)
    v_cmp_ne_u32 s[46:47], s41, v95
    v_cmp_ne_u32 s[48:49], s41, v99
    s_waitcnt vmcnt(0)
    v_cmp_ne_u32 s[50:51], s41, v103
    v_cmp_ne_u32 vcc, s41, v107
    s_or_b64 s[46:47], s[46:47], s[48:49]
    s_or_b64 vcc, vcc, s[50:51]
    s_or_b64 vcc, vcc, s[46:47]
    s_cbranch_vccnz L_conloop
L_condone:
    v_pk_add_f32 v[92:93], v[92:93], v[96:97]
    v_pk_add_f32 v[100:101], v[100:101], v[104:105]
    v_add_f32 v94, v94, v98
    v_add_f32 v102, v102, v106
    v_pk_add_f32 v[92:93], v[92:93], v[100:101]
    v_add_f32 v94, v94, v102
    v_lshlrev_b32 v89, 16, v89
    v_permlane32_swap_b32 v92, v96
    v_permlane32_swap_b32 v93, v97
    v_permlane32_swap_b32 v94, v98
    v_pk_add_f32 v[92:93], v[92:93], v[96:97]
    v_add_f32 v94, v94, v98
    s_mov_b32 exec_hi, 0
    v_cvt_pk_bf16_f32 v92, 0, v92
    v_cvt_pk_bf16_f32 v93, 0, v93
    v_cvt_pk_bf16_f32 v94, 0, v94
    v_pk_mul_f32 v[92:93], v[92:93], s[90:91]
    v_mul_f32 v94, s90, v94
    v_cvt_pk_bf16_f32 v96, 0, v92
    v_cvt_pk_bf16_f32 v99, 0, v94
    v_cvt_pk_bf16_f32 v97, 0, v93
    v_cvt_pk_bf16_f32 v98, 0, v93
    v_mov_b32_dpp v101, v96 wave_shl:1 row_mask:0xf bank_mask:0xf bound_ctrl:1
    v_mov_b32_dpp v102, v99 wave_shr:1 row_mask:0xf bank_mask:0xf bound_ctrl:1
    v_cvt_pk_bf16_f32 v100, 0, v94
    v_pk_mul_f32 v[40:41], v[96:97], s[52:53] op_sel_hi:[1,0]
    v_pk_mul_f32 v[42:43], v[98:99], s[52:53] op_sel:[0,1] op_sel_hi:[1,1]
    v_pk_mul_f32 v[44:45], v[100:101], v[88:89] op_sel:[0,1] op_sel_hi:[1,1]
    v_mul_f32 v46, s52, v102
    v_mul_f32 v47, s53, v96
    v_mul_f32 v48, v89, v97
    v_cvt_pk_bf16_f32 v40, 0, v40
    v_cvt_pk_bf16_f32 v41, 0, v41
    v_cvt_pk_bf16_f32 v42, 0, v42
    v_cvt_pk_bf16_f32 v43, 0, v43
    v_cvt_pk_bf16_f32 v46, 0, v46
    v_cvt_pk_bf16_f32 v47, 0, v47
    v_cvt_pk_bf16_f32 v44, 0, v44
    v_cvt_pk_bf16_f32 v45, 0, v45
    v_cvt_pk_bf16_f32 v48, 0, v48
    v_pk_add_f32 v[40:41], v[40:41], v[42:43]
    v_add_f32 v46, v46, v47
    v_cvt_pk_bf16_f32 v40, 0, v40
    v_cvt_pk_bf16_f32 v41, 0, v41
    v_cvt_pk_bf16_f32 v46, 0, v46
    v_pk_add_f32 v[40:41], v[40:41], v[44:45]
    v_add_f32 v46, v46, v48
    v_cvt_pk_bf16_f32 v40, 0, v40
    v_cvt_pk_bf16_f32 v41, 0, v41
    v_cvt_pk_bf16_f32 v46, 0, v46
    v_pk_mul_f32 v[40:41], v[40:41], s[92:93]
    v_mul_f32 v46, s92, v46
    v_exp_f32 v40, v40
    v_exp_f32 v41, v41
    v_exp_f32 v46, v46
    v_add_f32 v40, 1.0, v40
    v_add_f32 v41, 1.0, v41
    v_add_f32 v46, 1.0, v46
    v_rcp_f32 v46, v46
    v_rcp_f32 v40, v40
    v_rcp_f32 v41, v41
    v_cvt_pk_bf16_f32 v46, 0, v46
    v_cvt_pk_bf16_f32 v40, 0, v40
    v_cvt_pk_bf16_f32 v41, 0, v41
    ds_write_b32 v32, v46
    ds_write_b32 v33, v40
    ds_write_b32 v34, v41
    s_cmp_lg_u32 s2, 0
    s_waitcnt lgkmcnt(0)
    s_barrier
    s_cbranch_scc1 L_noepoch
    s_mov_b64 exec, 1
    global_store_dword v6, v95, s[12:13] sc1
L_noepoch:
    s_endpgm
L_toslow:
    s_waitcnt vmcnt(0)
    s_mov_b32 exec_hi, 0
    v_add_u32 v36, s39, v1
    v_add_u32 v37, 0x30000, v36
    s_mov_b32 s40, 1048576
L_own1:
    global_load_dwordx4 v[92:95], v36, s[12:13] sc1
    s_sub_u32 s40, s40, 1
    s_cbranch_scc1 L_own1_out
    s_waitcnt vmcnt(0)
    v_cmp_ne_u32 vcc, s41, v95
    s_cbranch_vccnz L_own1
L_own1_out:
    s_waitcnt vmcnt(0)
    global_store_dwordx4 v37, v[92:95], s[12:13] sc1
    s_mov_b32 exec_hi, -1
    s_waitcnt vmcnt(0)
    v_add_u32 v20, 0x30000, v20
    v_add_u32 v21, 0x30000, v21
    s_mov_b32 s40, 1048576
L_slowloop:
    global_load_dwordx4 v[92:95], v20, s[12:13] offset:-4096 sc1
    global_load_dwordx4 v[96:99], v20, s[12:13] sc1
    global_load_dwordx4 v[100:103], v21, s[12:13] offset:-4096 sc1
    global_load_dwordx4 v[104:107], v21, s[12:13] sc1
    s_sub_u32 s40, s40, 1
    s_cbranch_scc1 L_slowout
    s_waitcnt vmcnt(2)
    v_cmp_ne_u32 s[46:47], s41, v95
    v_cmp_ne_u32 s[48:49], s41, v99
    s_waitcnt vmcnt(0)
    v_cmp_ne_u32 s[50:51], s41, v103
    v_cmp_ne_u32 vcc, s41, v107
    s_or_b64 s[46:47], s[46:47], s[48:49]
    s_or_b64 vcc, vcc, s[50:51]
    s_or_b64 vcc, vcc, s[46:47]
    s_cbranch_vccnz L_slowloop
L_slowout:
    s_waitcnt vmcnt(0)
    s_branch L_reddone
L_preout:
    s_mov_b64 exec, -1
    s_waitcnt vmcnt(0)
    s_mov_b32 exec_hi, 0
    v_add_u32 v36, s39, v1
    v_add_u32 v37, 0x30000, v36
    s_mov_b32 s40, 1048576
L_own2:
    global_load_dwordx4 v[92:95], v36, s[12:13] sc1
    s_sub_u32 s40, s40, 1
    s_cbranch_scc1 L_own2_out
    s_waitcnt vmcnt(0)
    v_cmp_ne_u32 vcc, s41, v95
    s_cbranch_vccnz L_own2
L_own2_out:
    s_waitcnt vmcnt(0)
    global_store_dwordx4 v37, v[92:95], s[12:13] sc1
    s_mov_b32 exec_hi, -1
    s_waitcnt vmcnt(0)
    s_mov_b32 s40, 1048576
L_conslow:
    global_load_dwordx4 v[92:95], v7, s[12:13] offset:0 sc1
    global_load_dwordx4 v[96:99], v7, s[12:13] offset:1024 sc1
    global_load_dwordx4 v[100:103], v7, s[12:13] offset:2048 sc1
    global_load_dwordx4 v[104:107], v7, s[12:13] offset:3072 sc1
    s_sub_u32 s40, s40, 1
    s_cbranch_scc1 L_conout
    s_waitcnt vmcnt(2)
    v_cmp_ne_u32 s[46:47], s41, v95
    v_cmp_ne_u32 s[48:49], s41, v99
    s_waitcnt vmcnt(0)
    v_cmp_ne_u32 s[50:51], s41, v103
    v_cmp_ne_u32 vcc, s41, v107
    s_or_b64 s[46:47], s[46:47], s[48:49]
    s_or_b64 vcc, vcc, s[50:51]
    s_or_b64 vcc, vcc, s[46:47]
    s_cbranch_vccnz L_conslow
L_conout:
    s_waitcnt vmcnt(0)
    s_branch L_condone
.section .rodata,"a"
.p2align 6
.amdhsa_kernel standalone__channel_attn_eca__vision_kernel
  .amdhsa_next_free_vgpr 112
  .amdhsa_next_free_sgpr 96
  .amdhsa_accum_offset 112
  .amdhsa_group_segment_fixed_size 0
  .amdhsa_kernarg_size 40
  .amdhsa_user_sgpr_count 2
  .amdhsa_user_sgpr_kernarg_segment_ptr 1
  .amdhsa_system_sgpr_workgroup_id_x 1
  .amdhsa_float_denorm_mode_32 3
.end_amdhsa_kernel
```
